```python
import torch

def _softmax(x, axis=-1):
    return torch.softmax(x, dim=axis)
def _gelu(x):
    return torch.nn.functional.gelu(x, approximate="tanh")
def _silu(x):
    return torch.nn.functional.silu(x)
def _sigmoid(x):
    return torch.sigmoid(x)
def _layernorm(x, axis=-1, eps=1e-5):
    m = x.mean(dim=axis, keepdim=True)
    v = x.var(dim=axis, keepdim=True, unbiased=False)
    return (x - m) / torch.sqrt(v + eps)
def _scatter_add(tgt, idx, src, axis=0):
    return tgt.clone().index_add_(axis, idx, src)
def _segment_sum(src, seg, n):
    out = torch.zeros((n,) + src.shape[1:], dtype=src.dtype)
    return out.index_add_(0, seg, src)
def _pad(x, pw):
    flat = tuple(v for pair in reversed(pw) for v in pair)
    return torch.nn.functional.pad(x, flat)

kernel_name = 'standalone__deepnorm__sampling'

def setup_inputs():

    _w = (lambda a: (lambda t: t.to(torch.bfloat16) if t.is_floating_point() else t)(torch.as_tensor(a)))
    B, S, D = 1024, 16, 640
    return {
        "x": _w((lambda *s: torch.randn(*s, dtype=torch.bfloat16) * 0.05)(B, S, D)),
        "f": _w((lambda *s: torch.randn(*s, dtype=torch.bfloat16) * 0.05)(B, S, D)),
        "g": _w((lambda *s: torch.randn(*s, dtype=torch.bfloat16) * 0.05)(D) + 1.0),
        "b": _w((lambda *s: torch.randn(*s, dtype=torch.bfloat16) * 0.4)(D)),
        "alpha": _w(float(2.0)),
    }

def reference(x, f, g, b, alpha):
    return _layernorm(alpha * x + f, axis=-1) * g + b
```

```asm
; @launch grid=(256,1,1) block=(1024,1,1) lds=0
.amdgcn_target "amdgcn-amd-amdhsa--gfx950"
.text
.p2align 12
.globl standalone__deepnorm__sampling_kernel
.p2align 8
.type standalone__deepnorm__sampling_kernel,@function
standalone__deepnorm__sampling_kernel:
    s_load_dwordx8 s[4:11], s[0:1], 0
    v_readfirstlane_b32 s17, v0
    s_cmpk_ge_u32 s2, 0x100
    s_cbranch_scc1 L_end
    v_and_b32 v1, 15, v0
    s_bfe_u32 s3, s17, 0x20006
    s_and_b32 s16, s17, 0x100
    s_lshl3_add_u32 s3, s16, s3
    s_and_b32 s16, s17, 0x200
    s_lshl4_add_u32 s3, s16, s3
    s_and_b32 s16, s2, 3
    s_lshl2_add_u32 s3, s16, s3
    s_and_b32 s16, s2, 0x80
    s_add_u32 s16, s16, s2
    s_andn2_b32 s16, s16, 3
    s_lshl4_add_u32 s3, s16, s3
    s_mulk_i32 s3, 0x500
    v_lshlrev_b32 v1, 4, v1
    v_bfe_u32 v0, v0, 4, 2
    v_mul_u32_u24 v0, 0x5000, v0
    v_add3_u32 v0, v0, v1, s3
    s_waitcnt lgkmcnt(0)
    global_load_dwordx4 v[8:11], v0, s[4:5] offset:0 nt
    global_load_dwordx4 v[12:15], v0, s[4:5] offset:256 nt
    global_load_dwordx4 v[28:31], v0, s[6:7] offset:0 nt
    global_load_dwordx4 v[52:55], v1, s[8:9] offset:0
    global_load_dwordx4 v[60:63], v1, s[10:11] offset:0
    global_load_dwordx4 v[16:19], v0, s[4:5] offset:512 nt
    global_load_dwordx4 v[68:71], v1, s[8:9] offset:256
    global_load_dwordx4 v[32:35], v0, s[6:7] offset:256 nt
    global_load_dwordx4 v[76:79], v1, s[10:11] offset:256
    global_load_dwordx4 v[84:87], v1, s[8:9] offset:512
    global_load_dwordx4 v[20:23], v0, s[4:5] offset:768 nt
    global_load_dwordx4 v[92:95], v1, s[10:11] offset:512
    global_load_dwordx4 v[36:39], v0, s[6:7] offset:512 nt
    global_load_dwordx4 v[100:103], v1, s[8:9] offset:768
    global_load_dwordx4 v[108:111], v1, s[10:11] offset:768
    global_load_dwordx4 v[24:27], v0, s[4:5] offset:1024 nt
    global_load_dwordx4 v[116:119], v1, s[8:9] offset:1024
    global_load_dwordx4 v[40:43], v0, s[6:7] offset:768 nt
    global_load_dwordx4 v[124:127], v1, s[10:11] offset:1024
    global_load_dwordx4 v[44:47], v0, s[6:7] offset:1024 nt
    s_load_dwordx4 s[12:15], s[0:1], 32
    s_waitcnt lgkmcnt(0)
    s_load_dword s18, s[12:13], 0
    s_mov_b32 s16, 0xffff0000
    s_mov_b32 s20, 0x05040100
    s_mov_b32 s21, 0x07060302
    s_mov_b32 s22, 0x3727c5ac
    s_getreg_b32 s19, hwreg(HW_REG_XCC_ID, 0, 1)
    s_cmpk_ge_u32 s17, 0x300
    s_cselect_b32 s23, 1, 0
    s_lshl_b32 s23, s23, s19
    s_waitcnt lgkmcnt(0)
    s_pack_ll_b32_b16 s18, s18, 0x3f80
    s_cmp_eq_u32 s23, 2
    s_waitcnt vmcnt(17)
    s_cbranch_scc0 L_nobar0
    s_barrier
L_nobar0:
    v_perm_b32 v2, v28, v8, s20
    v_perm_b32 v28, v28, v8, s21
    v_dot2_f32_bf16 v8, v2, s18, 0
    v_dot2_f32_bf16 v28, v28, s18, 0
    v_perm_b32 v3, v29, v9, s20
    v_perm_b32 v29, v29, v9, s21
    v_dot2_f32_bf16 v9, v3, s18, 0
    v_dot2_f32_bf16 v29, v29, s18, 0
    v_perm_b32 v2, v30, v10, s20
    v_perm_b32 v30, v30, v10, s21
    v_dot2_f32_bf16 v10, v2, s18, 0
    v_dot2_f32_bf16 v30, v30, s18, 0
    v_perm_b32 v3, v31, v11, s20
    v_perm_b32 v31, v31, v11, s21
    v_dot2_f32_bf16 v11, v3, s18, 0
    v_dot2_f32_bf16 v31, v31, s18, 0
    v_pk_add_f32 v[4:5], v[8:9], v[28:29]
    s_nop 1
    v_pk_add_f32 v[6:7], v[10:11], v[30:31]
    v_pk_add_f32 v[4:5], v[4:5], v[6:7]
    v_add_f32 v1, v4, v5
    s_nop 1
    v_add_f32_dpp v1, v1, v1 row_ror:8 row_mask:0xf bank_mask:0xf
    s_nop 1
    v_add_f32_dpp v1, v1, v1 row_ror:4 row_mask:0xf bank_mask:0xf
    s_nop 1
    v_add_f32_dpp v1, v1, v1 row_ror:2 row_mask:0xf bank_mask:0xf
    s_nop 1
    v_add_f32_dpp v1, v1, v1 row_ror:1 row_mask:0xf bank_mask:0xf
    v_mul_f32 v1, 0xbc000000, v1
    v_pk_add_f32 v[8:9], v[8:9], v[0:1] op_sel:[0,1] op_sel_hi:[1,1]
    v_pk_add_f32 v[28:29], v[28:29], v[0:1] op_sel:[0,1] op_sel_hi:[1,1]
    v_pk_add_f32 v[10:11], v[10:11], v[0:1] op_sel:[0,1] op_sel_hi:[1,1]
    v_pk_add_f32 v[30:31], v[30:31], v[0:1] op_sel:[0,1] op_sel_hi:[1,1]
    v_pk_add_f32 v[4:5], v[8:9], v[28:29]
    v_pk_mul_f32 v[6:7], v[8:9], v[8:9]
    v_pk_fma_f32 v[6:7], v[28:29], v[28:29], v[6:7]
    v_pk_add_f32 v[4:5], v[4:5], v[10:11]
    v_pk_fma_f32 v[6:7], v[10:11], v[10:11], v[6:7]
    v_pk_add_f32 v[4:5], v[4:5], v[30:31]
    v_pk_fma_f32 v[6:7], v[30:31], v[30:31], v[6:7]
    s_waitcnt vmcnt(15)
    v_lshlrev_b32 v48, 16, v52
    v_lshlrev_b32 v49, 16, v53
    v_lshlrev_b32 v50, 16, v54
    v_lshlrev_b32 v51, 16, v55
    v_and_b32 v52, s16, v52
    v_and_b32 v53, s16, v53
    v_and_b32 v54, s16, v54
    v_and_b32 v55, s16, v55
    v_lshlrev_b32 v56, 16, v60
    v_lshlrev_b32 v57, 16, v61
    v_lshlrev_b32 v58, 16, v62
    v_lshlrev_b32 v59, 16, v63
    v_and_b32 v60, s16, v60
    v_and_b32 v61, s16, v61
    v_and_b32 v62, s16, v62
    v_and_b32 v63, s16, v63
    s_waitcnt vmcnt(13)
    v_lshlrev_b32 v64, 16, v68
    v_lshlrev_b32 v65, 16, v69
    v_lshlrev_b32 v66, 16, v70
    v_lshlrev_b32 v67, 16, v71
    v_and_b32 v68, s16, v68
    v_and_b32 v69, s16, v69
    v_and_b32 v70, s16, v70
    v_and_b32 v71, s16, v71
    s_cmp_eq_u32 s23, 1
    s_waitcnt vmcnt(12)
    s_cbranch_scc0 L_nobar1
    s_barrier
L_nobar1:
    v_perm_b32 v2, v32, v12, s20
    v_perm_b32 v32, v32, v12, s21
    v_dot2_f32_bf16 v12, v2, s18, v1
    v_dot2_f32_bf16 v32, v32, s18, v1
    v_perm_b32 v3, v33, v13, s20
    v_perm_b32 v33, v33, v13, s21
    v_dot2_f32_bf16 v13, v3, s18, v1
    v_dot2_f32_bf16 v33, v33, s18, v1
    v_perm_b32 v2, v34, v14, s20
    v_perm_b32 v34, v34, v14, s21
    v_dot2_f32_bf16 v14, v2, s18, v1
    v_dot2_f32_bf16 v34, v34, s18, v1
    v_perm_b32 v3, v35, v15, s20
    v_perm_b32 v35, v35, v15, s21
    v_dot2_f32_bf16 v15, v3, s18, v1
    v_dot2_f32_bf16 v35, v35, s18, v1
    v_pk_add_f32 v[4:5], v[4:5], v[12:13]
    v_pk_fma_f32 v[6:7], v[12:13], v[12:13], v[6:7]
    v_pk_add_f32 v[4:5], v[4:5], v[32:33]
    v_pk_fma_f32 v[6:7], v[32:33], v[32:33], v[6:7]
    v_pk_add_f32 v[4:5], v[4:5], v[14:15]
    v_pk_fma_f32 v[6:7], v[14:15], v[14:15], v[6:7]
    v_pk_add_f32 v[4:5], v[4:5], v[34:35]
    v_pk_fma_f32 v[6:7], v[34:35], v[34:35], v[6:7]
    s_waitcnt vmcnt(10)
    v_lshlrev_b32 v72, 16, v76
    v_lshlrev_b32 v73, 16, v77
    v_lshlrev_b32 v74, 16, v78
    v_lshlrev_b32 v75, 16, v79
    v_and_b32 v76, s16, v76
    v_and_b32 v77, s16, v77
    v_and_b32 v78, s16, v78
    v_and_b32 v79, s16, v79
    v_lshlrev_b32 v80, 16, v84
    v_lshlrev_b32 v81, 16, v85
    v_lshlrev_b32 v82, 16, v86
    v_lshlrev_b32 v83, 16, v87
    v_and_b32 v84, s16, v84
    v_and_b32 v85, s16, v85
    v_and_b32 v86, s16, v86
    v_and_b32 v87, s16, v87
    s_waitcnt vmcnt(8)
    v_lshlrev_b32 v88, 16, v92
    v_lshlrev_b32 v89, 16, v93
    v_lshlrev_b32 v90, 16, v94
    v_lshlrev_b32 v91, 16, v95
    v_and_b32 v92, s16, v92
    v_and_b32 v93, s16, v93
    v_and_b32 v94, s16, v94
    v_and_b32 v95, s16, v95
    s_waitcnt vmcnt(7)
    v_perm_b32 v2, v36, v16, s20
    v_perm_b32 v36, v36, v16, s21
    v_dot2_f32_bf16 v16, v2, s18, v1
    v_dot2_f32_bf16 v36, v36, s18, v1
    v_perm_b32 v3, v37, v17, s20
    v_perm_b32 v37, v37, v17, s21
    v_dot2_f32_bf16 v17, v3, s18, v1
    v_dot2_f32_bf16 v37, v37, s18, v1
    v_perm_b32 v2, v38, v18, s20
    v_perm_b32 v38, v38, v18, s21
    v_dot2_f32_bf16 v18, v2, s18, v1
    v_dot2_f32_bf16 v38, v38, s18, v1
    v_perm_b32 v3, v39, v19, s20
    v_perm_b32 v39, v39, v19, s21
    v_dot2_f32_bf16 v19, v3, s18, v1
    v_dot2_f32_bf16 v39, v39, s18, v1
    v_pk_add_f32 v[4:5], v[4:5], v[16:17]
    v_pk_fma_f32 v[6:7], v[16:17], v[16:17], v[6:7]
    v_pk_add_f32 v[4:5], v[4:5], v[36:37]
    v_pk_fma_f32 v[6:7], v[36:37], v[36:37], v[6:7]
    v_pk_add_f32 v[4:5], v[4:5], v[18:19]
    v_pk_fma_f32 v[6:7], v[18:19], v[18:19], v[6:7]
    v_pk_add_f32 v[4:5], v[4:5], v[38:39]
    v_pk_fma_f32 v[6:7], v[38:39], v[38:39], v[6:7]
    s_waitcnt vmcnt(5)
    v_lshlrev_b32 v96, 16, v100
    v_lshlrev_b32 v97, 16, v101
    v_lshlrev_b32 v98, 16, v102
    v_lshlrev_b32 v99, 16, v103
    v_and_b32 v100, s16, v100
    v_and_b32 v101, s16, v101
    v_and_b32 v102, s16, v102
    v_and_b32 v103, s16, v103
    v_lshlrev_b32 v104, 16, v108
    v_lshlrev_b32 v105, 16, v109
    v_lshlrev_b32 v106, 16, v110
    v_lshlrev_b32 v107, 16, v111
    v_and_b32 v108, s16, v108
    v_and_b32 v109, s16, v109
    v_and_b32 v110, s16, v110
    v_and_b32 v111, s16, v111
    s_waitcnt vmcnt(3)
    v_lshlrev_b32 v112, 16, v116
    v_lshlrev_b32 v113, 16, v117
    v_lshlrev_b32 v114, 16, v118
    v_lshlrev_b32 v115, 16, v119
    v_and_b32 v116, s16, v116
    v_and_b32 v117, s16, v117
    v_and_b32 v118, s16, v118
    v_and_b32 v119, s16, v119
    s_waitcnt vmcnt(2)
    v_perm_b32 v2, v40, v20, s20
    v_perm_b32 v40, v40, v20, s21
    v_dot2_f32_bf16 v20, v2, s18, v1
    v_dot2_f32_bf16 v40, v40, s18, v1
    v_perm_b32 v3, v41, v21, s20
    v_perm_b32 v41, v41, v21, s21
    v_dot2_f32_bf16 v21, v3, s18, v1
    v_dot2_f32_bf16 v41, v41, s18, v1
    v_perm_b32 v2, v42, v22, s20
    v_perm_b32 v42, v42, v22, s21
    v_dot2_f32_bf16 v22, v2, s18, v1
    v_dot2_f32_bf16 v42, v42, s18, v1
    v_perm_b32 v3, v43, v23, s20
    v_perm_b32 v43, v43, v23, s21
    v_dot2_f32_bf16 v23, v3, s18, v1
    v_dot2_f32_bf16 v43, v43, s18, v1
    v_pk_add_f32 v[4:5], v[4:5], v[20:21]
    v_pk_fma_f32 v[6:7], v[20:21], v[20:21], v[6:7]
    v_pk_add_f32 v[4:5], v[4:5], v[40:41]
    v_pk_fma_f32 v[6:7], v[40:41], v[40:41], v[6:7]
    v_pk_add_f32 v[4:5], v[4:5], v[22:23]
    v_pk_fma_f32 v[6:7], v[22:23], v[22:23], v[6:7]
    v_pk_add_f32 v[4:5], v[4:5], v[42:43]
    v_pk_fma_f32 v[6:7], v[42:43], v[42:43], v[6:7]
    s_waitcnt vmcnt(1)
    v_lshlrev_b32 v120, 16, v124
    v_lshlrev_b32 v121, 16, v125
    v_lshlrev_b32 v122, 16, v126
    v_lshlrev_b32 v123, 16, v127
    v_and_b32 v124, s16, v124
    v_and_b32 v125, s16, v125
    v_and_b32 v126, s16, v126
    v_and_b32 v127, s16, v127
    s_waitcnt vmcnt(0)
    v_perm_b32 v2, v44, v24, s20
    v_perm_b32 v44, v44, v24, s21
    v_dot2_f32_bf16 v24, v2, s18, v1
    v_dot2_f32_bf16 v44, v44, s18, v1
    v_perm_b32 v3, v45, v25, s20
    v_perm_b32 v45, v45, v25, s21
    v_dot2_f32_bf16 v25, v3, s18, v1
    v_dot2_f32_bf16 v45, v45, s18, v1
    v_perm_b32 v2, v46, v26, s20
    v_perm_b32 v46, v46, v26, s21
    v_dot2_f32_bf16 v26, v2, s18, v1
    v_dot2_f32_bf16 v46, v46, s18, v1
    v_perm_b32 v3, v47, v27, s20
    v_perm_b32 v47, v47, v27, s21
    v_dot2_f32_bf16 v27, v3, s18, v1
    v_dot2_f32_bf16 v47, v47, s18, v1
    v_pk_add_f32 v[4:5], v[4:5], v[24:25]
    v_pk_fma_f32 v[6:7], v[24:25], v[24:25], v[6:7]
    v_pk_add_f32 v[4:5], v[4:5], v[44:45]
    v_pk_fma_f32 v[6:7], v[44:45], v[44:45], v[6:7]
    v_pk_add_f32 v[4:5], v[4:5], v[26:27]
    v_pk_fma_f32 v[6:7], v[26:27], v[26:27], v[6:7]
    v_pk_add_f32 v[4:5], v[4:5], v[46:47]
    v_pk_fma_f32 v[6:7], v[46:47], v[46:47], v[6:7]
    v_add_f32 v4, v4, v5
    v_add_f32 v6, v6, v7
    v_mov_b32 v7, s22
    v_add_f32_dpp v4, v4, v4 row_ror:8 row_mask:0xf bank_mask:0xf
    v_add_f32_dpp v6, v6, v6 row_ror:8 row_mask:0xf bank_mask:0xf
    s_cmp_lg_u32 s19, 0
    v_add_f32_dpp v4, v4, v4 row_ror:4 row_mask:0xf bank_mask:0xf
    v_add_f32_dpp v6, v6, v6 row_ror:4 row_mask:0xf bank_mask:0xf
    s_cselect_b64 vcc, -1, 0
    v_add_f32_dpp v4, v4, v4 row_ror:2 row_mask:0xf bank_mask:0xf
    v_add_f32_dpp v6, v6, v6 row_ror:2 row_mask:0xf bank_mask:0xf
    s_cmp_lg_u32 s23, 0
    v_add_f32_dpp v4, v4, v4 row_ror:1 row_mask:0xf bank_mask:0xf
    v_add_f32_dpp v6, v6, v6 row_ror:1 row_mask:0xf bank_mask:0xf
    v_mul_f32 v4, 0xbacccccd, v4
    v_fmac_f32 v7, 0x3acccccd, v6
    v_fma_f32 v7, -v4, v4, v7
    v_maximum3_f32 v7, v7, s22, s22
    v_rsq_f32 v2, v7
    s_nop 0
    v_mul_f32 v3, v4, v2
    v_pk_fma_f32 v[8:9], v[8:9], v[2:3], v[2:3] op_sel:[0,0,1] op_sel_hi:[1,0,1]
    v_pk_fma_f32 v[28:29], v[28:29], v[2:3], v[2:3] op_sel:[0,0,1] op_sel_hi:[1,0,1]
    v_pk_fma_f32 v[8:9], v[8:9], v[48:49], v[56:57]
    v_pk_fma_f32 v[28:29], v[28:29], v[52:53], v[60:61]
    v_cvt_pk_bf16_f32 v8, v8, v28
    v_cvt_pk_bf16_f32 v9, v9, v29
    v_pk_fma_f32 v[10:11], v[10:11], v[2:3], v[2:3] op_sel:[0,0,1] op_sel_hi:[1,0,1]
    v_pk_fma_f32 v[30:31], v[30:31], v[2:3], v[2:3] op_sel:[0,0,1] op_sel_hi:[1,0,1]
    v_pk_fma_f32 v[10:11], v[10:11], v[50:51], v[58:59]
    v_pk_fma_f32 v[30:31], v[30:31], v[54:55], v[62:63]
    v_cvt_pk_bf16_f32 v10, v10, v30
    v_cvt_pk_bf16_f32 v11, v11, v31
    s_cbranch_scc0 L_hold0
    global_store_dwordx4 v0, v[8:11], s[14:15] offset:0 nt
L_hold0:
    v_pk_fma_f32 v[12:13], v[12:13], v[2:3], v[2:3] op_sel:[0,0,1] op_sel_hi:[1,0,1]
    v_pk_fma_f32 v[32:33], v[32:33], v[2:3], v[2:3] op_sel:[0,0,1] op_sel_hi:[1,0,1]
    v_pk_fma_f32 v[12:13], v[12:13], v[64:65], v[72:73]
    v_pk_fma_f32 v[32:33], v[32:33], v[68:69], v[76:77]
    v_cvt_pk_bf16_f32 v12, v12, v32
    v_cvt_pk_bf16_f32 v13, v13, v33
    v_pk_fma_f32 v[14:15], v[14:15], v[2:3], v[2:3] op_sel:[0,0,1] op_sel_hi:[1,0,1]
    v_pk_fma_f32 v[34:35], v[34:35], v[2:3], v[2:3] op_sel:[0,0,1] op_sel_hi:[1,0,1]
    v_pk_fma_f32 v[14:15], v[14:15], v[66:67], v[74:75]
    v_pk_fma_f32 v[34:35], v[34:35], v[70:71], v[78:79]
    v_cvt_pk_bf16_f32 v14, v14, v34
    v_cvt_pk_bf16_f32 v15, v15, v35
    s_cbranch_scc0 L_hold1
    global_store_dwordx4 v0, v[12:15], s[14:15] offset:256 nt
L_hold1:
    v_pk_fma_f32 v[16:17], v[16:17], v[2:3], v[2:3] op_sel:[0,0,1] op_sel_hi:[1,0,1]
    v_pk_fma_f32 v[36:37], v[36:37], v[2:3], v[2:3] op_sel:[0,0,1] op_sel_hi:[1,0,1]
    v_pk_fma_f32 v[16:17], v[16:17], v[80:81], v[88:89]
    v_pk_fma_f32 v[36:37], v[36:37], v[84:85], v[92:93]
    v_cvt_pk_bf16_f32 v16, v16, v36
    v_cvt_pk_bf16_f32 v17, v17, v37
    v_pk_fma_f32 v[18:19], v[18:19], v[2:3], v[2:3] op_sel:[0,0,1] op_sel_hi:[1,0,1]
    v_pk_fma_f32 v[38:39], v[38:39], v[2:3], v[2:3] op_sel:[0,0,1] op_sel_hi:[1,0,1]
    v_pk_fma_f32 v[18:19], v[18:19], v[82:83], v[90:91]
    v_pk_fma_f32 v[38:39], v[38:39], v[86:87], v[94:95]
    v_cvt_pk_bf16_f32 v18, v18, v38
    v_cvt_pk_bf16_f32 v19, v19, v39
    s_cbranch_scc0 L_hold2
    global_store_dwordx4 v0, v[16:19], s[14:15] offset:512 nt
L_hold2:
    v_pk_fma_f32 v[20:21], v[20:21], v[2:3], v[2:3] op_sel:[0,0,1] op_sel_hi:[1,0,1]
    v_pk_fma_f32 v[40:41], v[40:41], v[2:3], v[2:3] op_sel:[0,0,1] op_sel_hi:[1,0,1]
    v_pk_fma_f32 v[20:21], v[20:21], v[96:97], v[104:105]
    v_pk_fma_f32 v[40:41], v[40:41], v[100:101], v[108:109]
    v_cvt_pk_bf16_f32 v20, v20, v40
    v_cvt_pk_bf16_f32 v21, v21, v41
    v_pk_fma_f32 v[22:23], v[22:23], v[2:3], v[2:3] op_sel:[0,0,1] op_sel_hi:[1,0,1]
    v_pk_fma_f32 v[42:43], v[42:43], v[2:3], v[2:3] op_sel:[0,0,1] op_sel_hi:[1,0,1]
    v_pk_fma_f32 v[22:23], v[22:23], v[98:99], v[106:107]
    v_pk_fma_f32 v[42:43], v[42:43], v[102:103], v[110:111]
    v_cvt_pk_bf16_f32 v22, v22, v42
    v_cvt_pk_bf16_f32 v23, v23, v43
    s_cbranch_scc0 L_hold3
    global_store_dwordx4 v0, v[20:23], s[14:15] offset:768 nt
L_hold3:
    v_pk_fma_f32 v[24:25], v[24:25], v[2:3], v[2:3] op_sel:[0,0,1] op_sel_hi:[1,0,1]
    v_pk_fma_f32 v[44:45], v[44:45], v[2:3], v[2:3] op_sel:[0,0,1] op_sel_hi:[1,0,1]
    v_pk_fma_f32 v[24:25], v[24:25], v[112:113], v[120:121]
    v_pk_fma_f32 v[44:45], v[44:45], v[116:117], v[124:125]
    v_cvt_pk_bf16_f32 v24, v24, v44
    v_cvt_pk_bf16_f32 v25, v25, v45
    v_pk_fma_f32 v[26:27], v[26:27], v[2:3], v[2:3] op_sel:[0,0,1] op_sel_hi:[1,0,1]
    v_pk_fma_f32 v[46:47], v[46:47], v[2:3], v[2:3] op_sel:[0,0,1] op_sel_hi:[1,0,1]
    v_pk_fma_f32 v[26:27], v[26:27], v[114:115], v[122:123]
    v_pk_fma_f32 v[46:47], v[46:47], v[118:119], v[126:127]
    v_cvt_pk_bf16_f32 v26, v26, v46
    v_cvt_pk_bf16_f32 v27, v27, v47
    s_cbranch_scc1 L_last
L_bar:
    s_barrier
    global_store_dwordx4 v0, v[8:11], s[14:15] offset:0 nt
    global_store_dwordx4 v0, v[12:15], s[14:15] offset:256 nt
    global_store_dwordx4 v0, v[16:19], s[14:15] offset:512 nt
    global_store_dwordx4 v0, v[20:23], s[14:15] offset:768 nt
L_last:
    s_cbranch_vccnz L_odd
    global_store_dwordx4 v0, v[24:27], s[14:15] offset:1024 nt
    s_endpgm
L_odd:
    global_store_dwordx4 v0, v[24:27], s[14:15] offset:1024
L_end:
    s_endpgm
.section .rodata,"a"
.p2align 12
.fill 64, 4, 0
.p2align 6
.amdhsa_kernel standalone__deepnorm__sampling_kernel
  .amdhsa_next_free_vgpr 128
  .amdhsa_next_free_sgpr 24
  .amdhsa_accum_offset 128
  .amdhsa_group_segment_fixed_size 0
  .amdhsa_kernarg_size 64
  .amdhsa_user_sgpr_count 2
  .amdhsa_user_sgpr_kernarg_segment_ptr 1
  .amdhsa_system_sgpr_workgroup_id_x 1
  .amdhsa_float_denorm_mode_32 3
.end_amdhsa_kernel
```
